```python
import torch

def _softmax(x, axis=-1):
    return torch.softmax(x, dim=axis)
def _gelu(x):
    return torch.nn.functional.gelu(x, approximate="tanh")
def _silu(x):
    return torch.nn.functional.silu(x)
def _sigmoid(x):
    return torch.sigmoid(x)
def _layernorm(x, axis=-1, eps=1e-5):
    m = x.mean(dim=axis, keepdim=True)
    v = x.var(dim=axis, keepdim=True, unbiased=False)
    return (x - m) / torch.sqrt(v + eps)
def _scatter_add(tgt, idx, src, axis=0):
    return tgt.clone().index_add_(axis, idx, src)
def _segment_sum(src, seg, n):
    out = torch.zeros((n,) + src.shape[1:], dtype=src.dtype)
    return out.index_add_(0, seg, src)
def _pad(x, pw):
    flat = tuple(v for pair in reversed(pw) for v in pair)
    return torch.nn.functional.pad(x, flat)

kernel_name = 'standalone__low_rank_proj_linformer__prompt'

def setup_inputs():

    _w = (lambda a: (lambda t: t.to(torch.bfloat16) if t.is_floating_point() else t)(torch.as_tensor(a)))
    B, H, Sq, Skv, Dh, R = 1, 32, 2048, 2048, 192, 8
    return {
        "q": _w((lambda *s: torch.randn(*s, dtype=torch.bfloat16) * 0.8)(B, H, Sq, Dh)),
        "k": _w((lambda *s: torch.randn(*s, dtype=torch.bfloat16) * 0.8)(B, H, Skv, Dh)),
        "v": _w((lambda *s: torch.randn(*s, dtype=torch.bfloat16) * 0.05)(B, H, Skv, Dh)),
        "e_proj": _w((lambda *s: torch.randn(*s, dtype=torch.bfloat16) * 0.8)(R, Skv) * (Skv ** -0.5)),
        "f_proj": _w((lambda *s: torch.randn(*s, dtype=torch.bfloat16) * 0.05)(R, Skv) * (Skv ** -0.5)),
    }

def reference(q, k, v, e_proj, f_proj):
    B, H, Sq, Dh = q.shape
    kp = torch.einsum("rn,bhnd->bhrd", e_proj, k)
    vp = torch.einsum("rn,bhnd->bhrd", f_proj, v)
    scores = torch.einsum("bhqd,bhrd->bhqr", q, kp) * (Dh ** -0.5)
    p = _softmax(scores, axis=-1)
    o = torch.einsum("bhqr,bhrd->bhqd", p, vp)
    return o
```

```asm
; @launch grid=(256,1,1) block=(704,1,1) lds=112832
.amdgcn_target "amdgcn-amd-amdhsa--gfx950"
.text
.globl standalone__low_rank_proj_linformer__prompt_kernel
.p2align 8
.type standalone__low_rank_proj_linformer__prompt_kernel,@function
standalone__low_rank_proj_linformer__prompt_kernel:
    s_cmp_ge_u32 s2, 256
    s_cbranch_scc1 L_end
    s_load_dwordx16 s[4:19], s[0:1], 0
    v_lshrrev_b32 v1, 6, v0
    v_and_b32 v0, 63, v0
    v_readfirstlane_b32 s3, v1
    s_lshr_b32 s20, s2, 6
    s_lshl_b32 s20, s20, 3
    s_and_b32 s21, s2, 7
    s_add_u32 s20, s20, s21
    s_lshr_b32 s21, s2, 3
    s_and_b32 s21, s21, 7
    s_and_b32 s22, s21, 1
    s_lshr_b32 s23, s21, 1
    v_and_b32 v3, 7, v0
    v_lshrrev_b32 v4, 3, v0
    v_mul_u32_u24 v1, 3072, v4
    v_lshl_add_u32 v1, v3, 4, v1
    s_lshl_b32 s52, s3, 7
    v_add_u32 v5, s52, v1
    s_lshr_b32 s92, s2, 3
    s_add_u32 s92, s92, s2
    s_and_b32 s92, s92, 7
    s_mul_i32 s93, s92, 24576
    v_add_u32 v6, s93, v5
    s_mul_i32 s58, s20, 786432
    s_mul_i32 s59, s23, 196608
    s_add_u32 s59, s59, s58
    s_mov_b32 s26, 196608
    s_mov_b32 s27, 0x20000
    s_cmp_eq_u32 s22, 0
    s_waitcnt lgkmcnt(0)
    s_cselect_b32 s24, s6, s8
    s_cselect_b32 s25, s7, s9
    s_cselect_b32 s28, s10, s12
    s_cselect_b32 s29, s11, s13
    s_add_u32 s24, s24, s59
    s_addc_u32 s25, s25, 0
    s_cmp_ge_u32 s3, 3
    s_cbranch_scc1 L_notkv0
    buffer_load_dwordx4 v[12:15], v6, s[24:27], 0 offen offset:0 nt
    buffer_load_dwordx4 v[16:19], v6, s[24:27], 0 offen offset:384 nt
    buffer_load_dwordx4 v[20:23], v6, s[24:27], 0 offen offset:768 nt
    buffer_load_dwordx4 v[24:27], v6, s[24:27], 0 offen offset:1152 nt
    buffer_load_dwordx4 v[28:31], v6, s[24:27], 0 offen offset:1536 nt
    buffer_load_dwordx4 v[32:35], v6, s[24:27], 0 offen offset:1920 nt
    buffer_load_dwordx4 v[36:39], v6, s[24:27], 0 offen offset:2304 nt
    buffer_load_dwordx4 v[40:43], v6, s[24:27], 0 offen offset:2688 nt
    s_mov_b32 s30, 32768
    s_mov_b32 s31, 0x20000
    v_lshlrev_b32 v2, 12, v3
    v_lshl_add_u32 v2, v4, 4, v2
    s_lshl_b32 s55, s23, 10
    s_add_u32 s93, s92, 0
    s_and_b32 s93, s93, 7
    s_lshl_b32 s93, s93, 7
    s_add_u32 s93, s93, s55
    buffer_load_dwordx4 v[140:143], v2, s[28:31], s93 offen
    s_add_u32 s93, s92, 1
    s_and_b32 s93, s93, 7
    s_lshl_b32 s93, s93, 7
    s_add_u32 s93, s93, s55
    buffer_load_dwordx4 v[144:147], v2, s[28:31], s93 offen
L_notkv0:
    s_mov_b32 s30, 32768
    s_mov_b32 s31, 0x20000
    s_mul_i32 s59, s21, 98304
    s_add_u32 s58, s58, s59
    s_add_u32 s32, s4, s58
    s_addc_u32 s33, s5, 0
    s_mov_b32 s34, 98304
    s_mov_b32 s35, 0x20000
    s_add_u32 s36, s14, s58
    s_addc_u32 s37, s15, 0
    s_mov_b32 s38, 98304
    s_mov_b32 s39, 0x20000
    s_mul_i32 s58, s20, 49152
    s_add_u32 s40, s18, s58
    s_addc_u32 s41, s19, 0
    s_mov_b32 s42, 49152
    s_mov_b32 s43, 0x20000
    s_mov_b32 s44, s16
    s_mov_b32 s45, s17
    s_mov_b32 s46, 256
    s_mov_b32 s47, 0x20000
    s_mov_b32 s48, 0x05040100
    s_mov_b32 s49, 0x07060302
    s_mov_b32 s50, 0x3d93cd3a
    s_mov_b32 s51, 0x3fb8aa3b
    s_lshl_b32 s53, s22, 2
    s_add_u32 s53, s53, s23
    s_mul_i32 s53, s53, 6144
    s_cmp_lg_u32 s3, 10
    s_cbranch_scc1 L_noinit
    v_lshlrev_b32 v110, 2, v0
    v_add_u32 v110, 112768, v110
    v_mov_b32 v111, 0
    s_mov_b64 exec, 0xffff
    ds_write_b32 v110, v111
    s_mov_b64 exec, -1
    s_waitcnt lgkmcnt(0)
L_noinit:
    s_cmp_ge_u32 s3, 3
    s_cbranch_scc1 L_qwave
    v_mov_b32 v108, 0
    v_mov_b32 v109, 0
    v_mov_b32 v110, 0
    v_mov_b32 v111, 0
    v_mov_b32 v112, 0
    v_mov_b32 v113, 0
    v_mov_b32 v114, 0
    v_mov_b32 v115, 0
    v_mov_b32 v116, 0
    v_mov_b32 v117, 0
    v_mov_b32 v118, 0
    v_mov_b32 v119, 0
    v_mov_b32 v120, 0
    v_mov_b32 v121, 0
    v_mov_b32 v122, 0
    v_mov_b32 v123, 0
    v_mov_b32 v124, 0
    v_mov_b32 v125, 0
    v_mov_b32 v126, 0
    v_mov_b32 v127, 0
    v_mov_b32 v128, 0
    v_mov_b32 v129, 0
    v_mov_b32 v130, 0
    v_mov_b32 v131, 0
    v_mov_b32 v132, 0
    v_mov_b32 v133, 0
    v_mov_b32 v134, 0
    v_mov_b32 v135, 0
    v_mov_b32 v136, 0
    v_mov_b32 v137, 0
    v_mov_b32 v138, 0
    v_mov_b32 v139, 0
    v_lshlrev_b32 v11, 4, v0
    v_add_u32 v11, 98304, v11
    s_mov_b32 s54, 0
    s_setprio 2
    s_barrier
L_kvloop:
    s_lshl_b32 s55, s54, 1
    s_add_u32 s56, s55, 1
    s_add_u32 s93, s56, s92
    s_and_b32 s93, s93, 7
    s_mul_i32 s93, s93, 24576
    s_cmp_ge_u32 s56, 8
    s_cselect_b32 s93, 0x1000000, s93
    v_add_u32 v6, s93, v5
    s_add_u32 s56, s55, 2
    s_add_u32 s93, s56, s92
    s_and_b32 s93, s93, 7
    s_mul_i32 s93, s93, 24576
    s_cmp_ge_u32 s56, 8
    s_cselect_b32 s93, 0x1000000, s93
    v_add_u32 v7, s93, v5
    s_waitcnt vmcnt(6)
    buffer_load_dwordx4 v[44:47], v6, s[24:27], 0 offen offset:0 nt
    buffer_load_dwordx4 v[48:51], v6, s[24:27], 0 offen offset:384 nt
    v_perm_b32 v76, v16, v12, s48
    v_perm_b32 v80, v16, v12, s49
    v_perm_b32 v84, v17, v13, s48
    v_perm_b32 v88, v17, v13, s49
    v_perm_b32 v92, v18, v14, s48
    v_perm_b32 v96, v18, v14, s49
    v_perm_b32 v100, v19, v15, s48
    v_perm_b32 v104, v19, v15, s49
    s_waitcnt vmcnt(6)
    buffer_load_dwordx4 v[52:55], v6, s[24:27], 0 offen offset:768 nt
    buffer_load_dwordx4 v[56:59], v6, s[24:27], 0 offen offset:1152 nt
    v_perm_b32 v77, v24, v20, s48
    v_perm_b32 v81, v24, v20, s49
    v_perm_b32 v85, v25, v21, s48
    v_perm_b32 v89, v25, v21, s49
    v_perm_b32 v93, v26, v22, s48
    v_perm_b32 v97, v26, v22, s49
    v_perm_b32 v101, v27, v23, s48
    v_perm_b32 v105, v27, v23, s49
    s_waitcnt vmcnt(6)
    buffer_load_dwordx4 v[60:63], v6, s[24:27], 0 offen offset:1536 nt
    buffer_load_dwordx4 v[64:67], v6, s[24:27], 0 offen offset:1920 nt
    s_cmp_eq_u32 s54, 0
    s_cbranch_scc1 Lsk_1
    s_cmp_lg_u32 s54, 1
    s_cbranch_scc1 Lne_2
    s_mov_b32 s62, 4194304
    v_mov_b32 v148, 112780
LpE_3:
    ds_read_b32 v149, v148
    s_waitcnt lgkmcnt(0)
    v_readfirstlane_b32 s63, v149
    s_sub_u32 s62, s62, 1
    s_cbranch_scc1 LdE_4
    s_cmp_ge_u32 s63, 1
    s_cbranch_scc1 LdE_4
    s_sleep 1
    s_branch LpE_3
LdE_4:
Lne_2:
    s_add_u32 s93, s55, s92
    s_and_b32 s93, s93, 7
    s_lshl_b32 s93, s93, 10
    v_add_u32 v10, s93, v11
    ds_read_b128 v[140:143], v10
Lsk_1:
    v_perm_b32 v78, v32, v28, s48
    v_perm_b32 v82, v32, v28, s49
    v_perm_b32 v86, v33, v29, s48
    v_perm_b32 v90, v33, v29, s49
    v_perm_b32 v94, v34, v30, s48
    v_perm_b32 v98, v34, v30, s49
    v_perm_b32 v102, v35, v31, s48
    v_perm_b32 v106, v35, v31, s49
    s_waitcnt vmcnt(6)
    buffer_load_dwordx4 v[68:71], v6, s[24:27], 0 offen offset:2304 nt
    buffer_load_dwordx4 v[72:75], v6, s[24:27], 0 offen offset:2688 nt
    v_perm_b32 v79, v40, v36, s48
    v_perm_b32 v83, v40, v36, s49
    v_perm_b32 v87, v41, v37, s48
    v_perm_b32 v91, v41, v37, s49
    v_perm_b32 v95, v42, v38, s48
    v_perm_b32 v99, v42, v38, s49
    v_perm_b32 v103, v43, v39, s48
    v_perm_b32 v107, v43, v39, s49
    s_waitcnt lgkmcnt(0)
    s_nop 0
    v_mfma_f32_16x16x32_bf16 v[108:111], v[140:143], v[76:79], v[108:111]
    v_mfma_f32_16x16x32_bf16 v[112:115], v[140:143], v[80:83], v[112:115]
    v_mfma_f32_16x16x32_bf16 v[116:119], v[140:143], v[84:87], v[116:119]
    v_mfma_f32_16x16x32_bf16 v[120:123], v[140:143], v[88:91], v[120:123]
    v_mfma_f32_16x16x32_bf16 v[124:127], v[140:143], v[92:95], v[124:127]
    v_mfma_f32_16x16x32_bf16 v[128:131], v[140:143], v[96:99], v[128:131]
    v_mfma_f32_16x16x32_bf16 v[132:135], v[140:143], v[100:103], v[132:135]
    v_mfma_f32_16x16x32_bf16 v[136:139], v[140:143], v[104:107], v[136:139]
    s_waitcnt vmcnt(6)
    buffer_load_dwordx4 v[12:15], v7, s[24:27], 0 offen offset:0 nt
    buffer_load_dwordx4 v[16:19], v7, s[24:27], 0 offen offset:384 nt
    s_cmp_lg_u32 s54, 3
    s_cbranch_scc1 Lnt_5
    v_mov_b32 v148, 112768
    v_mov_b32 v149, 1
    s_mov_b64 exec, 1
    ds_add_u32 v148, v149
    s_mov_b64 exec, -1
Lnt_5:
    v_perm_b32 v76, v48, v44, s48
    v_perm_b32 v80, v48, v44, s49
    v_perm_b32 v84, v49, v45, s48
    v_perm_b32 v88, v49, v45, s49
    v_perm_b32 v92, v50, v46, s48
    v_perm_b32 v96, v50, v46, s49
    v_perm_b32 v100, v51, v47, s48
    v_perm_b32 v104, v51, v47, s49
    s_waitcnt vmcnt(6)
    buffer_load_dwordx4 v[20:23], v7, s[24:27], 0 offen offset:768 nt
    buffer_load_dwordx4 v[24:27], v7, s[24:27], 0 offen offset:1152 nt
    s_cmp_lg_u32 s54, 3
    s_cbranch_scc1 Lnt_6
    v_mov_b32 v148, 112768
    v_mov_b32 v149, 1
    s_mov_b64 exec, 1
    ds_add_u32 v148, v149
    s_mov_b64 exec, -1
Lnt_6:
    v_perm_b32 v77, v56, v52, s48
    v_perm_b32 v81, v56, v52, s49
    v_perm_b32 v85, v57, v53, s48
    v_perm_b32 v89, v57, v53, s49
    v_perm_b32 v93, v58, v54, s48
    v_perm_b32 v97, v58, v54, s49
    v_perm_b32 v101, v59, v55, s48
    v_perm_b32 v105, v59, v55, s49
    s_waitcnt vmcnt(6)
    buffer_load_dwordx4 v[28:31], v7, s[24:27], 0 offen offset:1536 nt
    buffer_load_dwordx4 v[32:35], v7, s[24:27], 0 offen offset:1920 nt
    s_cmp_lg_u32 s54, 3
    s_cbranch_scc1 Lnt_7
    v_mov_b32 v148, 112768
    v_mov_b32 v149, 1
    s_mov_b64 exec, 1
    ds_add_u32 v148, v149
    s_mov_b64 exec, -1
Lnt_7:
    s_cmp_eq_u32 s54, 0
    s_cbranch_scc1 Lsk_8
    s_add_u32 s93, s55, s92
    s_add_u32 s93, s93, 1
    s_and_b32 s93, s93, 7
    s_lshl_b32 s93, s93, 10
    v_add_u32 v10, s93, v11
    ds_read_b128 v[144:147], v10
Lsk_8:
    v_perm_b32 v78, v64, v60, s48
    v_perm_b32 v82, v64, v60, s49
    v_perm_b32 v86, v65, v61, s48
    v_perm_b32 v90, v65, v61, s49
    v_perm_b32 v94, v66, v62, s48
    v_perm_b32 v98, v66, v62, s49
    v_perm_b32 v102, v67, v63, s48
    v_perm_b32 v106, v67, v63, s49
    s_waitcnt vmcnt(6)
    buffer_load_dwordx4 v[36:39], v7, s[24:27], 0 offen offset:2304 nt
    buffer_load_dwordx4 v[40:43], v7, s[24:27], 0 offen offset:2688 nt
    s_cmp_lg_u32 s54, 3
    s_cbranch_scc1 Lnt_9
    v_mov_b32 v148, 112768
    v_mov_b32 v149, 1
    s_mov_b64 exec, 1
    ds_add_u32 v148, v149
    s_mov_b64 exec, -1
Lnt_9:
    v_perm_b32 v79, v72, v68, s48
    v_perm_b32 v83, v72, v68, s49
    v_perm_b32 v87, v73, v69, s48
    v_perm_b32 v91, v73, v69, s49
    v_perm_b32 v95, v74, v70, s48
    v_perm_b32 v99, v74, v70, s49
    v_perm_b32 v103, v75, v71, s48
    v_perm_b32 v107, v75, v71, s49
    s_waitcnt lgkmcnt(0)
    s_nop 0
    v_mfma_f32_16x16x32_bf16 v[108:111], v[144:147], v[76:79], v[108:111]
    v_mfma_f32_16x16x32_bf16 v[112:115], v[144:147], v[80:83], v[112:115]
    v_mfma_f32_16x16x32_bf16 v[116:119], v[144:147], v[84:87], v[116:119]
    v_mfma_f32_16x16x32_bf16 v[120:123], v[144:147], v[88:91], v[120:123]
    v_mfma_f32_16x16x32_bf16 v[124:127], v[144:147], v[92:95], v[124:127]
    v_mfma_f32_16x16x32_bf16 v[128:131], v[144:147], v[96:99], v[128:131]
    v_mfma_f32_16x16x32_bf16 v[132:135], v[144:147], v[100:103], v[132:135]
    v_mfma_f32_16x16x32_bf16 v[136:139], v[144:147], v[104:107], v[136:139]
    s_cmp_lg_u32 s54, 0
    s_cbranch_scc1 Lgo_10
    v_mov_b32 v148, 112788
    v_mov_b32 v149, 1
    s_mov_b64 exec, 1
    ds_add_u32 v148, v149
    s_mov_b64 exec, -1
Lgo_10:
    s_add_u32 s54, s54, 1
    s_cmp_lt_u32 s54, 4
    s_cbranch_scc1 L_kvloop
    s_mov_b32 s52, s3
    v_lshrrev_b32 v9, 5, v0
    v_lshlrev_b32 v9, 10, v9
    v_bfe_u32 v8, v0, 4, 1
    v_lshl_add_u32 v9, v8, 7, v9
    v_and_b32 v8, 7, v0
    v_lshl_add_u32 v9, v8, 4, v9
    s_lshl_b32 s58, s52, 11
    v_add_u32 v9, s58, v9
    v_lshlrev_b32 v3, 4, v0
    v_add_u32 v3, s58, v3
    v_mov_b32 v148, 112768
    ds_read_b32 v149, v148 offset:8
    v_permlane32_swap_b32 v108, v124
    v_permlane32_swap_b32 v109, v125
    v_permlane32_swap_b32 v110, v126
    v_permlane32_swap_b32 v111, v127
    v_permlane32_swap_b32 v112, v128
    v_permlane32_swap_b32 v113, v129
    v_permlane32_swap_b32 v114, v130
    v_permlane32_swap_b32 v115, v131
    v_permlane32_swap_b32 v116, v132
    v_permlane32_swap_b32 v117, v133
    v_permlane32_swap_b32 v118, v134
    v_permlane32_swap_b32 v119, v135
    v_permlane32_swap_b32 v120, v136
    v_permlane32_swap_b32 v121, v137
    v_permlane32_swap_b32 v122, v138
    v_permlane32_swap_b32 v123, v139
    v_add_f32_dpp v108, v124, v108 row_ror:8 row_mask:0xf bank_mask:0xf
    v_add_f32_dpp v109, v125, v109 row_ror:8 row_mask:0xf bank_mask:0xf
    v_add_f32_dpp v110, v126, v110 row_ror:8 row_mask:0xf bank_mask:0xf
    v_add_f32_dpp v111, v127, v111 row_ror:8 row_mask:0xf bank_mask:0xf
    v_add_f32_dpp v112, v128, v112 row_ror:8 row_mask:0xf bank_mask:0xf
    v_add_f32_dpp v113, v129, v113 row_ror:8 row_mask:0xf bank_mask:0xf
    v_add_f32_dpp v114, v130, v114 row_ror:8 row_mask:0xf bank_mask:0xf
    v_add_f32_dpp v115, v131, v115 row_ror:8 row_mask:0xf bank_mask:0xf
    v_add_f32_dpp v116, v132, v116 row_ror:8 row_mask:0xf bank_mask:0xf
    v_add_f32_dpp v117, v133, v117 row_ror:8 row_mask:0xf bank_mask:0xf
    v_add_f32_dpp v118, v134, v118 row_ror:8 row_mask:0xf bank_mask:0xf
    v_add_f32_dpp v119, v135, v119 row_ror:8 row_mask:0xf bank_mask:0xf
    v_add_f32_dpp v120, v136, v120 row_ror:8 row_mask:0xf bank_mask:0xf
    v_add_f32_dpp v121, v137, v121 row_ror:8 row_mask:0xf bank_mask:0xf
    v_add_f32_dpp v122, v138, v122 row_ror:8 row_mask:0xf bank_mask:0xf
    v_add_f32_dpp v123, v139, v123 row_ror:8 row_mask:0xf bank_mask:0xf
    v_min_u32 v108, -2, v108
    v_min_u32 v109, -2, v109
    v_min_u32 v110, -2, v110
    v_min_u32 v111, -2, v111
    v_min_u32 v112, -2, v112
    v_min_u32 v113, -2, v113
    v_min_u32 v114, -2, v114
    v_min_u32 v115, -2, v115
    v_min_u32 v116, -2, v116
    v_min_u32 v117, -2, v117
    v_min_u32 v118, -2, v118
    v_min_u32 v119, -2, v119
    v_min_u32 v120, -2, v120
    v_min_u32 v121, -2, v121
    v_min_u32 v122, -2, v122
    v_min_u32 v123, -2, v123
    s_waitcnt lgkmcnt(0)
    v_readfirstlane_b32 s63, v149
    s_cmp_lg_u32 s63, 0
    s_cbranch_scc1 L_modeok
    s_mov_b32 s62, 4194304
    v_mov_b32 v148, 112776
LpM_11:
    ds_read_b32 v149, v148
    s_waitcnt lgkmcnt(0)
    v_readfirstlane_b32 s63, v149
    s_sub_u32 s62, s62, 1
    s_cbranch_scc1 LdM_12
    s_cmp_ge_u32 s63, 1
    s_cbranch_scc1 LdM_12
    s_sleep 1
    s_branch LpM_11
LdM_12:
L_modeok:
    s_mov_b32 s61, s63
    s_mov_b32 exec_lo, 0x00ff00ff
    s_mov_b32 exec_hi, 0x00ff00ff
    s_cmp_eq_u32 s61, 2
    s_cbranch_scc1 L_pubfast
    buffer_store_dwordx4 v[108:111], v9, s[40:43], s53 offen offset:0 sc1
    buffer_store_dwordx4 v[112:115], v9, s[40:43], s53 offen offset:256 sc1
    buffer_store_dwordx4 v[116:119], v9, s[40:43], s53 offen offset:512 sc1
    buffer_store_dwordx4 v[120:123], v9, s[40:43], s53 offen offset:768 sc1
    s_branch L_pubdone
L_pubfast:
    buffer_store_dwordx4 v[108:111], v9, s[40:43], s53 offen offset:0
    buffer_store_dwordx4 v[112:115], v9, s[40:43], s53 offen offset:256
    buffer_store_dwordx4 v[116:119], v9, s[40:43], s53 offen offset:512
    buffer_store_dwordx4 v[120:123], v9, s[40:43], s53 offen offset:768
L_pubdone:
    s_mov_b64 exec, -1
    s_mov_b32 s57, 0xff
    s_mov_b32 s62, 65536
L_collect:
    s_cmp_eq_u32 s61, 2
    s_cbranch_scc0 L_colslow
    s_bitcmp1_b32 s57, 0
    s_cbranch_scc0 Lc_13
    s_mov_b32 s58, 0
    buffer_load_dwordx4 v[12:15], v3, s[40:43], s58 offen offset:0 nt
    buffer_load_dwordx4 v[16:19], v3, s[40:43], s58 offen offset:1024 nt
Lc_13:
    s_bitcmp1_b32 s57, 1
    s_cbranch_scc0 Lc_14
    s_mov_b32 s58, 6144
    buffer_load_dwordx4 v[20:23], v3, s[40:43], s58 offen offset:0 nt
    buffer_load_dwordx4 v[24:27], v3, s[40:43], s58 offen offset:1024 nt
Lc_14:
    s_bitcmp1_b32 s57, 2
    s_cbranch_scc0 Lc_15
    s_mov_b32 s58, 12288
    buffer_load_dwordx4 v[28:31], v3, s[40:43], s58 offen offset:0 nt
    buffer_load_dwordx4 v[32:35], v3, s[40:43], s58 offen offset:1024 nt
Lc_15:
    s_bitcmp1_b32 s57, 3
    s_cbranch_scc0 Lc_16
    s_mov_b32 s58, 18432
    buffer_load_dwordx4 v[36:39], v3, s[40:43], s58 offen offset:0 nt
    buffer_load_dwordx4 v[40:43], v3, s[40:43], s58 offen offset:1024 nt
Lc_16:
    s_bitcmp1_b32 s57, 4
    s_cbranch_scc0 Lc_17
    s_mov_b32 s58, 24576
    buffer_load_dwordx4 v[44:47], v3, s[40:43], s58 offen offset:0 nt
    buffer_load_dwordx4 v[48:51], v3, s[40:43], s58 offen offset:1024 nt
Lc_17:
    s_bitcmp1_b32 s57, 5
    s_cbranch_scc0 Lc_18
    s_mov_b32 s58, 30720
    buffer_load_dwordx4 v[52:55], v3, s[40:43], s58 offen offset:0 nt
    buffer_load_dwordx4 v[56:59], v3, s[40:43], s58 offen offset:1024 nt
Lc_18:
    s_bitcmp1_b32 s57, 6
    s_cbranch_scc0 Lc_19
    s_mov_b32 s58, 36864
    buffer_load_dwordx4 v[60:63], v3, s[40:43], s58 offen offset:0 nt
    buffer_load_dwordx4 v[64:67], v3, s[40:43], s58 offen offset:1024 nt
Lc_19:
    s_bitcmp1_b32 s57, 7
    s_cbranch_scc0 Lc_20
    s_mov_b32 s58, 43008
    buffer_load_dwordx4 v[68:71], v3, s[40:43], s58 offen offset:0 nt
    buffer_load_dwordx4 v[72:75], v3, s[40:43], s58 offen offset:1024 nt
Lc_20:
    s_branch L_colwait
L_colslow:
    s_bitcmp1_b32 s57, 0
    s_cbranch_scc0 Lc_21
    s_mov_b32 s58, 0
    buffer_load_dwordx4 v[12:15], v3, s[40:43], s58 offen offset:0 sc1
    buffer_load_dwordx4 v[16:19], v3, s[40:43], s58 offen offset:1024 sc1
Lc_21:
    s_bitcmp1_b32 s57, 1
    s_cbranch_scc0 Lc_22
    s_mov_b32 s58, 6144
    buffer_load_dwordx4 v[20:23], v3, s[40:43], s58 offen offset:0 sc1
    buffer_load_dwordx4 v[24:27], v3, s[40:43], s58 offen offset:1024 sc1
Lc_22:
    s_bitcmp1_b32 s57, 2
    s_cbranch_scc0 Lc_23
    s_mov_b32 s58, 12288
    buffer_load_dwordx4 v[28:31], v3, s[40:43], s58 offen offset:0 sc1
    buffer_load_dwordx4 v[32:35], v3, s[40:43], s58 offen offset:1024 sc1
Lc_23:
    s_bitcmp1_b32 s57, 3
    s_cbranch_scc0 Lc_24
    s_mov_b32 s58, 18432
    buffer_load_dwordx4 v[36:39], v3, s[40:43], s58 offen offset:0 sc1
    buffer_load_dwordx4 v[40:43], v3, s[40:43], s58 offen offset:1024 sc1
Lc_24:
    s_bitcmp1_b32 s57, 4
    s_cbranch_scc0 Lc_25
    s_mov_b32 s58, 24576
    buffer_load_dwordx4 v[44:47], v3, s[40:43], s58 offen offset:0 sc1
    buffer_load_dwordx4 v[48:51], v3, s[40:43], s58 offen offset:1024 sc1
Lc_25:
    s_bitcmp1_b32 s57, 5
    s_cbranch_scc0 Lc_26
    s_mov_b32 s58, 30720
    buffer_load_dwordx4 v[52:55], v3, s[40:43], s58 offen offset:0 sc1
    buffer_load_dwordx4 v[56:59], v3, s[40:43], s58 offen offset:1024 sc1
Lc_26:
    s_bitcmp1_b32 s57, 6
    s_cbranch_scc0 Lc_27
    s_mov_b32 s58, 36864
    buffer_load_dwordx4 v[60:63], v3, s[40:43], s58 offen offset:0 sc1
    buffer_load_dwordx4 v[64:67], v3, s[40:43], s58 offen offset:1024 sc1
Lc_27:
    s_bitcmp1_b32 s57, 7
    s_cbranch_scc0 Lc_28
    s_mov_b32 s58, 43008
    buffer_load_dwordx4 v[68:71], v3, s[40:43], s58 offen offset:0 sc1
    buffer_load_dwordx4 v[72:75], v3, s[40:43], s58 offen offset:1024 sc1
Lc_28:
L_colwait:
    v_bfe_u32 v6, v0, 3, 1
    v_and_b32 v7, 7, v0
    v_lshrrev_b32 v2, 4, v0
    v_mul_u32_u24 v140, 1600, v6
    v_lshl_add_u32 v140, v7, 4, v140
    v_lshl_add_u32 v140, v2, 1, v140
    s_lshl_b32 s58, s52, 7
    s_add_u32 s58, s58, 106496
    v_add_u32 v140, s58, v140
    v_lshl_add_u32 v141, v7, 3, v2
    v_lshlrev_b32 v141, 4, v141
    v_lshl_add_u32 v141, v6, 3, v141
    s_lshl_b32 s58, s52, 10
    s_add_u32 s58, s58, 109696
    v_add_u32 v141, s58, v141
    s_waitcnt vmcnt(0)
L_colchk:
    s_bitcmp1_b32 s57, 0
    s_cbranch_scc0 Lk_29
    v_max3_u32 v8, v12, v13, v14
    v_max3_u32 v8, v8, v15, v16
    v_max3_u32 v8, v8, v17, v18
    v_max_u32 v8, v8, v19
    v_cmp_eq_u32 vcc, -1, v8
    s_cbranch_vccnz Lk_29
    s_bitset0_b32 s57, 0
Lk_29:
    s_bitcmp1_b32 s57, 1
    s_cbranch_scc0 Lk_30
    v_max3_u32 v8, v20, v21, v22
    v_max3_u32 v8, v8, v23, v24
    v_max3_u32 v8, v8, v25, v26
    v_max_u32 v8, v8, v27
    v_cmp_eq_u32 vcc, -1, v8
    s_cbranch_vccnz Lk_30
    s_bitset0_b32 s57, 1
Lk_30:
    s_bitcmp1_b32 s57, 2
    s_cbranch_scc0 Lk_31
    v_max3_u32 v8, v28, v29, v30
    v_max3_u32 v8, v8, v31, v32
    v_max3_u32 v8, v8, v33, v34
    v_max_u32 v8, v8, v35
    v_cmp_eq_u32 vcc, -1, v8
    s_cbranch_vccnz Lk_31
    s_bitset0_b32 s57, 2
Lk_31:
    s_bitcmp1_b32 s57, 3
    s_cbranch_scc0 Lk_32
    v_max3_u32 v8, v36, v37, v38
    v_max3_u32 v8, v8, v39, v40
    v_max3_u32 v8, v8, v41, v42
    v_max_u32 v8, v8, v43
    v_cmp_eq_u32 vcc, -1, v8
    s_cbranch_vccnz Lk_32
    s_bitset0_b32 s57, 3
Lk_32:
    s_bitcmp1_b32 s57, 4
    s_cbranch_scc0 Lk_33
    v_max3_u32 v8, v44, v45, v46
    v_max3_u32 v8, v8, v47, v48
    v_max3_u32 v8, v8, v49, v50
    v_max_u32 v8, v8, v51
    v_cmp_eq_u32 vcc, -1, v8
    s_cbranch_vccnz Lk_33
    s_bitset0_b32 s57, 4
Lk_33:
    s_bitcmp1_b32 s57, 5
    s_cbranch_scc0 Lk_34
    v_max3_u32 v8, v52, v53, v54
    v_max3_u32 v8, v8, v55, v56
    v_max3_u32 v8, v8, v57, v58
    v_max_u32 v8, v8, v59
    v_cmp_eq_u32 vcc, -1, v8
    s_cbranch_vccnz Lk_34
    s_bitset0_b32 s57, 5
Lk_34:
    s_bitcmp1_b32 s57, 6
    s_cbranch_scc0 Lk_35
    v_max3_u32 v8, v60, v61, v62
    v_max3_u32 v8, v8, v63, v64
    v_max3_u32 v8, v8, v65, v66
    v_max_u32 v8, v8, v67
    v_cmp_eq_u32 vcc, -1, v8
    s_cbranch_vccnz Lk_35
    s_bitset0_b32 s57, 6
Lk_35:
    s_bitcmp1_b32 s57, 7
    s_cbranch_scc0 Lk_36
    v_max3_u32 v8, v68, v69, v70
    v_max3_u32 v8, v8, v71, v72
    v_max3_u32 v8, v8, v73, v74
    v_max_u32 v8, v8, v75
    v_cmp_eq_u32 vcc, -1, v8
    s_cbranch_vccnz Lk_36
    s_bitset0_b32 s57, 7
Lk_36:
    s_cmp_eq_u32 s57, 0
    s_cbranch_scc1 L_collected0
    s_sub_u32 s62, s62, 1
    s_cbranch_scc0 L_collect
L_collected0:
L_collected:
    v_pk_add_f32 v[76:77], v[12:13], v[20:21]
    v_pk_add_f32 v[92:93], v[28:29], v[36:37]
    v_pk_add_f32 v[78:79], v[14:15], v[22:23]
    v_pk_add_f32 v[94:95], v[30:31], v[38:39]
    v_pk_add_f32 v[80:81], v[16:17], v[24:25]
    v_pk_add_f32 v[96:97], v[32:33], v[40:41]
    v_pk_add_f32 v[82:83], v[18:19], v[26:27]
    v_pk_add_f32 v[98:99], v[34:35], v[42:43]
    v_pk_add_f32 v[84:85], v[44:45], v[52:53]
    v_pk_add_f32 v[100:101], v[60:61], v[68:69]
    v_pk_add_f32 v[86:87], v[46:47], v[54:55]
    v_pk_add_f32 v[102:103], v[62:63], v[70:71]
    v_pk_add_f32 v[88:89], v[48:49], v[56:57]
    v_pk_add_f32 v[104:105], v[64:65], v[72:73]
    v_pk_add_f32 v[90:91], v[50:51], v[58:59]
    v_pk_add_f32 v[106:107], v[66:67], v[74:75]
    v_pk_add_f32 v[76:77], v[76:77], v[92:93]
    v_pk_add_f32 v[78:79], v[78:79], v[94:95]
    v_pk_add_f32 v[80:81], v[80:81], v[96:97]
    v_pk_add_f32 v[82:83], v[82:83], v[98:99]
    v_pk_add_f32 v[84:85], v[84:85], v[100:101]
    v_pk_add_f32 v[86:87], v[86:87], v[102:103]
    v_pk_add_f32 v[88:89], v[88:89], v[104:105]
    v_pk_add_f32 v[90:91], v[90:91], v[106:107]
    v_cvt_pk_bf16_f32 v124, v76, v77
    v_cvt_pk_bf16_f32 v125, v78, v79
    v_cvt_pk_bf16_f32 v126, v80, v81
    v_cvt_pk_bf16_f32 v127, v82, v83
    ds_write_b16 v140, v124 offset:0
    ds_write_b16_d16_hi v140, v124 offset:400
    ds_write_b16 v140, v125 offset:800
    ds_write_b16_d16_hi v140, v125 offset:1200
    ds_write_b16 v140, v126 offset:8
    ds_write_b16_d16_hi v140, v126 offset:408
    ds_write_b16 v140, v127 offset:808
    ds_write_b16_d16_hi v140, v127 offset:1208
    v_cvt_pk_bf16_f32 v128, v84, v85
    v_cvt_pk_bf16_f32 v129, v86, v87
    v_cvt_pk_bf16_f32 v130, v88, v89
    v_cvt_pk_bf16_f32 v131, v90, v91
    ds_write_b64 v141, v[128:129] offset:0
    ds_write_b64 v141, v[130:131] offset:64
    s_waitcnt lgkmcnt(0)
    v_mov_b32 v148, 112772
    v_mov_b32 v149, 1
    s_mov_b64 exec, 1
    ds_add_u32 v148, v149
    s_mov_b64 exec, -1
    s_branch L_fin
L_qwave:
    s_barrier
    v_add_u32 v110, 0, v0
    v_mul_u32_u24 v111, 2731, v110
    v_lshrrev_b32 v111, 17, v111
    v_and_b32 v111, 7, v111
    v_lshlrev_b32 v111, 4, v111
    v_lshlrev_b32 v110, 4, v110
    v_xor_b32 v140, v110, v111
    v_add_u32 v110, 64, v0
    v_mul_u32_u24 v111, 2731, v110
    v_lshrrev_b32 v111, 17, v111
    v_and_b32 v111, 7, v111
    v_lshlrev_b32 v111, 4, v111
    v_lshlrev_b32 v110, 4, v110
    v_xor_b32 v141, v110, v111
    v_add_u32 v110, 128, v0
    v_mul_u32_u24 v111, 2731, v110
    v_lshrrev_b32 v111, 17, v111
    v_and_b32 v111, 7, v111
    v_lshlrev_b32 v111, 4, v111
    v_lshlrev_b32 v110, 4, v110
    v_xor_b32 v142, v110, v111
    v_add_u32 v110, 192, v0
    v_mul_u32_u24 v111, 2731, v110
    v_lshrrev_b32 v111, 17, v111
    v_and_b32 v111, 7, v111
    v_lshlrev_b32 v111, 4, v111
    v_lshlrev_b32 v110, 4, v110
    v_xor_b32 v143, v110, v111
    v_add_u32 v110, 256, v0
    v_mul_u32_u24 v111, 2731, v110
    v_lshrrev_b32 v111, 17, v111
    v_and_b32 v111, 7, v111
    v_lshlrev_b32 v111, 4, v111
    v_lshlrev_b32 v110, 4, v110
    v_xor_b32 v144, v110, v111
    v_add_u32 v110, 320, v0
    v_mul_u32_u24 v111, 2731, v110
    v_lshrrev_b32 v111, 17, v111
    v_and_b32 v111, 7, v111
    v_lshlrev_b32 v111, 4, v111
    v_lshlrev_b32 v110, 4, v110
    v_xor_b32 v145, v110, v111
    s_sub_u32 s55, s3, 3
    s_mul_i32 s56, s55, 12288
    s_cmp_eq_u32 s3, 3
    s_cbranch_scc1 L_aux
    s_cmp_eq_u32 s3, 4
    s_cbranch_scc0 L_qmain
    v_and_b32 v3, 7, v0
    v_lshrrev_b32 v4, 3, v0
    v_lshlrev_b32 v2, 12, v3
    v_lshl_add_u32 v2, v4, 4, v2
    s_lshl_b32 s58, s23, 10
    s_mov_b32 m0, 98304
    s_nop 0
    buffer_load_dwordx4 v2, s[28:31], s58 offen lds
    s_add_u32 s58, s58, 128
    s_mov_b32 m0, 99328
    s_nop 0
    buffer_load_dwordx4 v2, s[28:31], s58 offen lds
    s_add_u32 s58, s58, 128
    s_mov_b32 m0, 100352
    s_nop 0
    buffer_load_dwordx4 v2, s[28:31], s58 offen lds
    s_add_u32 s58, s58, 128
    s_mov_b32 m0, 101376
    s_nop 0
    buffer_load_dwordx4 v2, s[28:31], s58 offen lds
    s_add_u32 s58, s58, 128
    s_mov_b32 m0, 102400
    s_nop 0
    buffer_load_dwordx4 v2, s[28:31], s58 offen lds
    s_add_u32 s58, s58, 128
    s_mov_b32 m0, 103424
    s_nop 0
    buffer_load_dwordx4 v2, s[28:31], s58 offen lds
    s_add_u32 s58, s58, 128
    s_mov_b32 m0, 104448
    s_nop 0
    buffer_load_dwordx4 v2, s[28:31], s58 offen lds
    s_add_u32 s58, s58, 128
    s_mov_b32 m0, 105472
    s_nop 0
    buffer_load_dwordx4 v2, s[28:31], s58 offen lds
    s_waitcnt vmcnt(0)
    v_mov_b32 v148, 112780
    v_mov_b32 v149, 1
    s_mov_b64 exec, 1
    ds_add_u32 v148, v149
    s_mov_b64 exec, -1
    s_branch L_qmain
L_aux:
    s_mov_b32 s62, 4194304
    v_mov_b32 v148, 112788
LpG_37:
    ds_read_b32 v149, v148
    s_waitcnt lgkmcnt(0)
    v_readfirstlane_b32 s63, v149
    s_sub_u32 s62, s62, 1
    s_cbranch_scc1 LdG_38
    s_cmp_ge_u32 s63, 1
    s_cbranch_scc1 LdG_38
    s_sleep 4
    s_branch LpG_37
LdG_38:
    v_lshlrev_b32 v1, 4, v0
    v_mov_b32 v12, -1
    v_mov_b32 v13, -1
    v_mov_b32 v14, -1
    v_mov_b32 v15, -1
    s_mov_b32 s58, s53
    buffer_store_dwordx4 v[12:15], v1, s[40:43], s58 offen offset:0
    buffer_store_dwordx4 v[12:15], v1, s[40:43], s58 offen offset:1024
    buffer_store_dwordx4 v[12:15], v1, s[40:43], s58 offen offset:2048
    buffer_store_dwordx4 v[12:15], v1, s[40:43], s58 offen offset:3072
    s_add_u32 s58, s58, 4096
    buffer_store_dwordx4 v[12:15], v1, s[40:43], s58 offen offset:0
    buffer_store_dwordx4 v[12:15], v1, s[40:43], s58 offen offset:1024
    s_waitcnt vmcnt(0)
    s_getreg_b32 s57, hwreg(HW_REG_XCC_ID)
    s_and_b32 s57, s57, 7
    s_or_b32 s57, s57, 0x80
    v_mov_b32 v2, s57
    s_lshl_b32 s59, s20, 3
    s_add_u32 s58, s59, s21
    s_mul_i32 s57, s57, 0x01010101
    s_mov_b64 exec, 1
    buffer_store_byte v2, off, s[44:47], s58
    s_mov_b32 s62, 6
L_auxpoll:
    s_sleep 6
    buffer_load_dwordx2 v[4:5], off, s[44:47], s59 sc1
    s_waitcnt vmcnt(0)
    v_and_b32 v4, 0xbfbfbfbf, v4
    v_xor_b32 v4, s57, v4
    v_and_b32 v5, 0xbfbfbfbf, v5
    v_xor_b32 v5, s57, v5
    v_or_b32 v4, v4, v5
    s_nop 0
    v_readfirstlane_b32 s60, v4
    s_cmp_eq_u32 s60, 0
    s_cbranch_scc1 L_auxfast
    s_sub_u32 s62, s62, 1
    s_cbranch_scc0 L_auxpoll
L_auxslow:
    s_mov_b64 exec, -1
    s_mov_b32 s58, s53
    buffer_store_dwordx4 v[12:15], v1, s[40:43], s58 offen offset:0 sc1
    buffer_store_dwordx4 v[12:15], v1, s[40:43], s58 offen offset:1024 sc1
    buffer_store_dwordx4 v[12:15], v1, s[40:43], s58 offen offset:2048 sc1
    buffer_store_dwordx4 v[12:15], v1, s[40:43], s58 offen offset:3072 sc1
    s_add_u32 s58, s58, 4096
    buffer_store_dwordx4 v[12:15], v1, s[40:43], s58 offen offset:0 sc1
    buffer_store_dwordx4 v[12:15], v1, s[40:43], s58 offen offset:1024 sc1
    s_waitcnt vmcnt(0)
    s_add_u32 s58, s59, s21
    s_or_b32 s60, s57, 0x40
    v_mov_b32 v2, s60
    s_mov_b64 exec, 1
    buffer_store_byte v2, off, s[44:47], s58 sc1
    s_mov_b32 s62, 65536
L_slowpoll:
    buffer_load_dwordx2 v[4:5], off, s[44:47], s59 sc1
    v_mov_b32 v8, 0
    v_mov_b32 v9, 0
    buffer_atomic_or_x2 v[8:9], off, s[44:47], s59 sc0 sc1
    s_waitcnt vmcnt(0)
    v_mov_b32 v12, 0
    v_and_b32 v13, 0xbfbfbfbf, v4
    v_xor_b32 v13, s57, v13
    v_and_b32 v14, 0x7f7f7f7f, v13
    v_add_u32 v14, 0x7f7f7f7f, v14
    v_or_b32 v14, v14, v13
    v_not_b32 v14, v14
    v_lshrrev_b32 v14, 1, v14
    v_or_b32 v14, v14, v8
    v_and_b32 v14, 0x40404040, v14
    v_xor_b32 v14, 0x40404040, v14
    v_or_b32 v12, v12, v14
    v_and_b32 v13, 0xbfbfbfbf, v5
    v_xor_b32 v13, s57, v13
    v_and_b32 v14, 0x7f7f7f7f, v13
    v_add_u32 v14, 0x7f7f7f7f, v14
    v_or_b32 v14, v14, v13
    v_not_b32 v14, v14
    v_lshrrev_b32 v14, 1, v14
    v_or_b32 v14, v14, v9
    v_and_b32 v14, 0x40404040, v14
    v_xor_b32 v14, 0x40404040, v14
    v_or_b32 v12, v12, v14
    s_nop 0
    v_readfirstlane_b32 s60, v12
    s_cmp_eq_u32 s60, 0
    s_cbranch_scc1 L_slowok
    s_sub_u32 s62, s62, 1
    s_cbranch_scc1 L_slowok
    s_sleep 32
    s_branch L_slowpoll
L_slowok:
    s_mov_b64 exec, -1
    v_mov_b32 v148, 112776
    v_mov_b32 v149, 1
    s_mov_b64 exec, 1
    ds_add_u32 v148, v149
    s_mov_b64 exec, -1
    s_branch L_auxdone
L_auxfast:
    s_mov_b64 exec, -1
    v_mov_b32 v148, 112776
    v_mov_b32 v149, 2
    s_mov_b64 exec, 1
    ds_add_u32 v148, v149
    s_mov_b64 exec, -1
L_auxdone:
L_qmain:
    v_and_b32 v138, 15, v0
    v_lshrrev_b32 v139, 4, v0
    v_lshrrev_b32 v132, 1, v138
    v_xor_b32 v132, v132, v139
    v_lshlrev_b32 v132, 4, v132
    v_mul_u32_u24 v133, 384, v138
    v_add_u32 v132, v132, v133
    v_add_u32 v132, s56, v132
    v_xor_b32 v133, 64, v132
    v_and_b32 v134, 7, v0
    v_mul_u32_u24 v134, 400, v134
    v_lshl_add_u32 v134, v139, 4, v134
    v_add_u32 v134, 106496, v134
    v_lshrrev_b32 v146, 2, v138
    v_and_b32 v147, 3, v138
    v_lshl_add_u32 v135, v146, 3, v147
    v_lshlrev_b32 v135, 4, v135
    v_and_b32 v147, 1, v139
    v_lshl_add_u32 v135, v147, 3, v135
    v_add_u32 v135, 109696, v135
    v_lshlrev_b32 v136, 4, v0
    v_cmp_gt_u32 vcc, 32, v0
    v_mov_b32 v137, 0
    s_nop 0
    v_cndmask_b32_e64 v137, v137, 1.0, vcc
    s_sub_u32 s57, s3, 3
    s_mul_i32 s57, s57, 12
    s_lshr_b32 s57, s57, 3
    s_add_u32 s57, s57, 1
    s_mov_b32 s62, 4194304
    v_mov_b32 v148, 112768
LpT_39:
    ds_read_b32 v149, v148
    s_waitcnt lgkmcnt(0)
    v_readfirstlane_b32 s63, v149
    s_sub_u32 s62, s62, 1
    s_cbranch_scc1 LdT_40
    s_cmp_ge_u32 s63, s57
    s_cbranch_scc1 LdT_40
    s_sleep 1
    s_branch LpT_39
LdT_40:
    s_add_u32 s57, s56, 6144
    s_add_u32 m0, s56, 0
    s_nop 0
    buffer_load_dwordx4 v140, s[32:35], s56 offen nt lds
    s_add_u32 m0, s56, 1024
    s_nop 0
    buffer_load_dwordx4 v141, s[32:35], s56 offen nt lds
    s_add_u32 m0, s56, 2048
    s_nop 0
    buffer_load_dwordx4 v142, s[32:35], s56 offen nt lds
Lnb_41:
    s_getreg_b32 s63, hwreg(HW_REG_IB_STS, 0, 4)
    s_cmp_le_u32 s63, 2
    s_cbranch_scc1 Lnbg_42
    ds_read_b32 v149, v148 offset:4
    s_waitcnt lgkmcnt(0)
    v_readfirstlane_b32 s63, v149
    s_cmp_ge_u32 s63, 3
    s_cbranch_scc1 L_rest3
    s_sleep 1
    s_branch Lnb_41
Lnbg_42:
    s_add_u32 m0, s56, 3072
    s_nop 0
    buffer_load_dwordx4 v143, s[32:35], s56 offen nt lds
Lnb_43:
    s_getreg_b32 s63, hwreg(HW_REG_IB_STS, 0, 4)
    s_cmp_le_u32 s63, 2
    s_cbranch_scc1 Lnbg_44
    ds_read_b32 v149, v148 offset:4
    s_waitcnt lgkmcnt(0)
    v_readfirstlane_b32 s63, v149
    s_cmp_ge_u32 s63, 3
    s_cbranch_scc1 L_rest4
    s_sleep 1
    s_branch Lnb_43
Lnbg_44:
    s_add_u32 m0, s56, 4096
    s_nop 0
    buffer_load_dwordx4 v144, s[32:35], s56 offen nt lds
Lnb_45:
    s_getreg_b32 s63, hwreg(HW_REG_IB_STS, 0, 4)
    s_cmp_le_u32 s63, 2
    s_cbranch_scc1 Lnbg_46
    ds_read_b32 v149, v148 offset:4
    s_waitcnt lgkmcnt(0)
    v_readfirstlane_b32 s63, v149
    s_cmp_ge_u32 s63, 3
    s_cbranch_scc1 L_rest5
    s_sleep 1
    s_branch Lnb_45
Lnbg_46:
    s_add_u32 m0, s56, 5120
    s_nop 0
    buffer_load_dwordx4 v145, s[32:35], s56 offen nt lds
Lnb_47:
    s_getreg_b32 s63, hwreg(HW_REG_IB_STS, 0, 4)
    s_cmp_le_u32 s63, 2
    s_cbranch_scc1 Lnbg_48
    ds_read_b32 v149, v148 offset:4
    s_waitcnt lgkmcnt(0)
    v_readfirstlane_b32 s63, v149
    s_cmp_ge_u32 s63, 3
    s_cbranch_scc1 L_rest6
    s_sleep 1
    s_branch Lnb_47
Lnbg_48:
    s_add_u32 m0, s56, 6144
    s_add_u32 s57, s56, 6144
    buffer_load_dwordx4 v140, s[32:35], s57 offen nt lds
Lnb_49:
    s_getreg_b32 s63, hwreg(HW_REG_IB_STS, 0, 4)
    s_cmp_le_u32 s63, 2
    s_cbranch_scc1 Lnbg_50
    ds_read_b32 v149, v148 offset:4
    s_waitcnt lgkmcnt(0)
    v_readfirstlane_b32 s63, v149
    s_cmp_ge_u32 s63, 3
    s_cbranch_scc1 L_rest7
    s_sleep 1
    s_branch Lnb_49
Lnbg_50:
    s_add_u32 m0, s56, 7168
    s_nop 0
    buffer_load_dwordx4 v141, s[32:35], s57 offen nt lds
Lnb_51:
    s_getreg_b32 s63, hwreg(HW_REG_IB_STS, 0, 4)
    s_cmp_le_u32 s63, 2
    s_cbranch_scc1 Lnbg_52
    ds_read_b32 v149, v148 offset:4
    s_waitcnt lgkmcnt(0)
    v_readfirstlane_b32 s63, v149
    s_cmp_ge_u32 s63, 3
    s_cbranch_scc1 L_rest8
    s_sleep 1
    s_branch Lnb_51
Lnbg_52:
    s_add_u32 m0, s56, 8192
    s_nop 0
    buffer_load_dwordx4 v142, s[32:35], s57 offen nt lds
Lnb_53:
    s_getreg_b32 s63, hwreg(HW_REG_IB_STS, 0, 4)
    s_cmp_le_u32 s63, 2
    s_cbranch_scc1 Lnbg_54
    ds_read_b32 v149, v148 offset:4
    s_waitcnt lgkmcnt(0)
    v_readfirstlane_b32 s63, v149
    s_cmp_ge_u32 s63, 3
    s_cbranch_scc1 L_rest9
    s_sleep 1
    s_branch Lnb_53
Lnbg_54:
    s_add_u32 m0, s56, 9216
    s_nop 0
    buffer_load_dwordx4 v143, s[32:35], s57 offen nt lds
Lnb_55:
    s_getreg_b32 s63, hwreg(HW_REG_IB_STS, 0, 4)
    s_cmp_le_u32 s63, 2
    s_cbranch_scc1 Lnbg_56
    ds_read_b32 v149, v148 offset:4
    s_waitcnt lgkmcnt(0)
    v_readfirstlane_b32 s63, v149
    s_cmp_ge_u32 s63, 3
    s_cbranch_scc1 L_rest10
    s_sleep 1
    s_branch Lnb_55
Lnbg_56:
    s_add_u32 m0, s56, 10240
    s_nop 0
    buffer_load_dwordx4 v144, s[32:35], s57 offen nt lds
Lnb_57:
    s_getreg_b32 s63, hwreg(HW_REG_IB_STS, 0, 4)
    s_cmp_le_u32 s63, 2
    s_cbranch_scc1 Lnbg_58
    ds_read_b32 v149, v148 offset:4
    s_waitcnt lgkmcnt(0)
    v_readfirstlane_b32 s63, v149
    s_cmp_ge_u32 s63, 3
    s_cbranch_scc1 L_rest11
    s_sleep 1
    s_branch Lnb_57
Lnbg_58:
    s_add_u32 m0, s56, 11264
    s_nop 0
    buffer_load_dwordx4 v145, s[32:35], s57 offen nt lds
    s_branch L_allissued
L_rest3:
    s_add_u32 m0, s56, 3072
    s_nop 0
    buffer_load_dwordx4 v143, s[32:35], s56 offen nt lds
L_rest4:
    s_add_u32 m0, s56, 4096
    s_nop 0
    buffer_load_dwordx4 v144, s[32:35], s56 offen nt lds
L_rest5:
    s_add_u32 m0, s56, 5120
    s_nop 0
    buffer_load_dwordx4 v145, s[32:35], s56 offen nt lds
L_rest6:
    s_add_u32 m0, s56, 6144
    s_add_u32 s57, s56, 6144
    buffer_load_dwordx4 v140, s[32:35], s57 offen nt lds
L_rest7:
    s_add_u32 m0, s56, 7168
    s_nop 0
    buffer_load_dwordx4 v141, s[32:35], s57 offen nt lds
L_rest8:
    s_add_u32 m0, s56, 8192
    s_nop 0
    buffer_load_dwordx4 v142, s[32:35], s57 offen nt lds
L_rest9:
    s_add_u32 m0, s56, 9216
    s_nop 0
    buffer_load_dwordx4 v143, s[32:35], s57 offen nt lds
L_rest10:
    s_add_u32 m0, s56, 10240
    s_nop 0
    buffer_load_dwordx4 v144, s[32:35], s57 offen nt lds
L_rest11:
    s_add_u32 m0, s56, 11264
    s_nop 0
    buffer_load_dwordx4 v145, s[32:35], s57 offen nt lds
L_allissued:
    v_mov_b32 v148, 112784
    v_mov_b32 v149, 1
    s_mov_b64 exec, 1
    ds_add_u32 v148, v149
    s_mov_b64 exec, -1
    s_waitcnt vmcnt(6)
    ds_read_b128 v[52:55], v132 offset:0
    ds_read_b128 v[56:59], v133 offset:0
    ds_read_b128 v[60:63], v132 offset:128
    ds_read_b128 v[64:67], v133 offset:128
    ds_read_b128 v[68:71], v132 offset:256
    ds_read_b128 v[72:75], v133 offset:256
    s_mov_b32 s62, 4194304
    v_mov_b32 v148, 112772
LpR_59:
    ds_read_b32 v149, v148
    s_waitcnt lgkmcnt(0)
    v_readfirstlane_b32 s63, v149
    s_sub_u32 s62, s62, 1
    s_cbranch_scc1 LdR_60
    s_cmp_ge_u32 s63, 3
    s_cbranch_scc1 LdR_60
    s_sleep 1
    s_branch LpR_59
LdR_60:
    ds_read_b128 v[4:7], v134 offset:0
    ds_read_b128 v[8:11], v134 offset:64
    ds_read_b128 v[12:15], v134 offset:128
    ds_read_b128 v[16:19], v134 offset:192
    ds_read_b128 v[20:23], v134 offset:256
    ds_read_b128 v[24:27], v134 offset:320
    ds_read_b64 v[28:29], v135 offset:0
    ds_read_b64 v[30:31], v135 offset:64
    ds_read_b64 v[32:33], v135 offset:512
    ds_read_b64 v[34:35], v135 offset:576
    ds_read_b64 v[36:37], v135 offset:1024
    ds_read_b64 v[38:39], v135 offset:1088
    ds_read_b64 v[40:41], v135 offset:1536
    ds_read_b64 v[42:43], v135 offset:1600
    ds_read_b64 v[44:45], v135 offset:2048
    ds_read_b64 v[46:47], v135 offset:2112
    ds_read_b64 v[48:49], v135 offset:2560
    ds_read_b64 v[50:51], v135 offset:2624
    s_mov_b32 s55, 0
    s_waitcnt lgkmcnt(12)
    s_branch L_tile1
L_tile:
    s_waitcnt vmcnt(6)
    ds_read_b128 v[52:55], v132 offset:0
    ds_read_b128 v[56:59], v133 offset:0
    ds_read_b128 v[60:63], v132 offset:128
    ds_read_b128 v[64:67], v133 offset:128
    ds_read_b128 v[68:71], v132 offset:256
    ds_read_b128 v[72:75], v133 offset:256
    s_waitcnt lgkmcnt(0)
L_tile1:
    v_mfma_f32_16x16x32_bf16 v[76:79], v[4:7], v[52:55], 0
    v_mfma_f32_16x16x32_bf16 v[76:79], v[8:11], v[56:59], v[76:79]
    v_mfma_f32_16x16x32_bf16 v[76:79], v[12:15], v[60:63], v[76:79]
    v_mfma_f32_16x16x32_bf16 v[76:79], v[16:19], v[64:67], v[76:79]
    v_mfma_f32_16x16x32_bf16 v[76:79], v[20:23], v[68:71], v[76:79]
    v_mfma_f32_16x16x32_bf16 v[76:79], v[24:27], v[72:75], v[76:79]
    s_add_u32 s58, s56, 4096
    s_nop 6
    v_cvt_pk_bf16_f32 v80, v76, v77
    v_cvt_pk_bf16_f32 v81, v78, v79
    v_lshlrev_b32 v76, 16, v80
    v_and_b32 v77, 0xffff0000, v80
    v_lshlrev_b32 v78, 16, v81
    v_and_b32 v79, 0xffff0000, v81
    v_mul_f32 v76, s50, v76
    v_mul_f32 v77, s50, v77
    v_mul_f32 v78, s50, v78
    v_mul_f32 v79, s50, v79
    v_cvt_pk_bf16_f32 v80, v76, v77
    v_cvt_pk_bf16_f32 v81, v78, v79
    v_lshlrev_b32 v76, 16, v80
    v_and_b32 v77, 0xffff0000, v80
    v_lshlrev_b32 v78, 16, v81
    v_and_b32 v79, 0xffff0000, v81
    v_max3_f32 v82, v76, v77, v78
    v_max_f32 v82, v82, v79
    v_mov_b32 v83, v82
    s_nop 1
    v_permlane16_swap_b32 v82, v83
    s_nop 1
    v_max_f32 v82, v82, v83
    v_mul_f32 v82, s51, v82
    v_fma_f32 v76, v76, s51, -v82
    v_fma_f32 v77, v77, s51, -v82
    v_fma_f32 v78, v78, s51, -v82
    v_fma_f32 v79, v79, s51, -v82
    v_exp_f32 v76, v76
    v_exp_f32 v77, v77
    v_exp_f32 v78, v78
    v_exp_f32 v79, v79
    s_nop 0
    v_add_f32 v82, v76, v77
    v_add_f32 v83, v78, v79
    v_add_f32 v82, v82, v83
    v_mov_b32 v83, v82
    s_nop 1
    v_permlane16_swap_b32 v82, v83
    s_nop 1
    v_add_f32 v82, v82, v83
    v_rcp_f32 v82, v82
    s_nop 0
    v_mul_f32 v82, v82, v137
    v_mul_f32 v76, v76, v82
    v_mul_f32 v77, v77, v82
    v_mul_f32 v78, v78, v82
    v_mul_f32 v79, v79, v82
    v_cvt_pk_bf16_f32 v80, v76, v77
    v_cvt_pk_bf16_f32 v81, v78, v79
    s_waitcnt lgkmcnt(0)
    s_nop 0
    v_mfma_f32_16x16x16_bf16 v[84:87], v[28:29], v[80:81], 0
    v_mfma_f32_16x16x16_bf16 v[88:91], v[30:31], v[80:81], 0
    v_mfma_f32_16x16x16_bf16 v[92:95], v[32:33], v[80:81], 0
    v_mfma_f32_16x16x16_bf16 v[96:99], v[34:35], v[80:81], 0
    v_mfma_f32_16x16x16_bf16 v[100:103], v[36:37], v[80:81], 0
    v_mfma_f32_16x16x16_bf16 v[104:107], v[38:39], v[80:81], 0
    v_mfma_f32_16x16x16_bf16 v[108:111], v[40:41], v[80:81], 0
    v_mfma_f32_16x16x16_bf16 v[112:115], v[42:43], v[80:81], 0
    v_mfma_f32_16x16x16_bf16 v[116:119], v[44:45], v[80:81], 0
    v_mfma_f32_16x16x16_bf16 v[120:123], v[46:47], v[80:81], 0
    v_mfma_f32_16x16x16_bf16 v[124:127], v[48:49], v[80:81], 0
    v_mfma_f32_16x16x16_bf16 v[128:131], v[50:51], v[80:81], 0
    s_nop 1
    v_cvt_pk_bf16_f32 v84, v84, v85
    v_cvt_pk_bf16_f32 v85, v86, v87
    v_cvt_pk_bf16_f32 v86, v88, v89
    v_cvt_pk_bf16_f32 v87, v90, v91
    ds_write_b128 v132, v[84:87] offset:0
    v_cvt_pk_bf16_f32 v92, v92, v93
    v_cvt_pk_bf16_f32 v93, v94, v95
    v_cvt_pk_bf16_f32 v94, v96, v97
    v_cvt_pk_bf16_f32 v95, v98, v99
    ds_write_b128 v133, v[92:95] offset:0
    v_cvt_pk_bf16_f32 v100, v100, v101
    v_cvt_pk_bf16_f32 v101, v102, v103
    v_cvt_pk_bf16_f32 v102, v104, v105
    v_cvt_pk_bf16_f32 v103, v106, v107
    ds_write_b128 v132, v[100:103] offset:128
    v_cvt_pk_bf16_f32 v108, v108, v109
    v_cvt_pk_bf16_f32 v109, v110, v111
    v_cvt_pk_bf16_f32 v110, v112, v113
    v_cvt_pk_bf16_f32 v111, v114, v115
    ds_write_b128 v133, v[108:111] offset:128
    v_cvt_pk_bf16_f32 v116, v116, v117
    v_cvt_pk_bf16_f32 v117, v118, v119
    v_cvt_pk_bf16_f32 v118, v120, v121
    v_cvt_pk_bf16_f32 v119, v122, v123
    ds_write_b128 v132, v[116:119] offset:256
    v_cvt_pk_bf16_f32 v124, v124, v125
    v_cvt_pk_bf16_f32 v125, v126, v127
    v_cvt_pk_bf16_f32 v126, v128, v129
    v_cvt_pk_bf16_f32 v127, v130, v131
    ds_write_b128 v133, v[124:127] offset:256
    s_waitcnt lgkmcnt(0)
    s_cmp_lg_u32 s55, 0
    s_cbranch_scc1 Lqi_61
    s_mov_b32 s62, 4194304
    v_mov_b32 v148, 112784
LpI_62:
    ds_read_b32 v149, v148
    s_waitcnt lgkmcnt(0)
    v_readfirstlane_b32 s63, v149
    s_sub_u32 s62, s62, 1
    s_cbranch_scc1 LdI_63
    s_cmp_ge_u32 s63, 8
    s_cbranch_scc1 LdI_63
    s_sleep 1
    s_branch LpI_62
LdI_63:
Lqi_61:
    v_add_u32 v84, s56, v140
    v_add_u32 v85, s56, v141
    v_add_u32 v86, s56, v142
    v_add_u32 v87, s56, v143
    v_add_u32 v88, s56, v144
    v_add_u32 v89, s56, v145
    ds_read_b128 v[52:55], v84
    ds_read_b128 v[56:59], v85
    ds_read_b128 v[60:63], v86
    ds_read_b128 v[64:67], v87
    ds_read_b128 v[68:71], v88
    ds_read_b128 v[72:75], v89
    s_waitcnt lgkmcnt(5)
    buffer_store_dwordx4 v[52:55], v136, s[36:39], s56 offen offset:0 nt
    s_waitcnt lgkmcnt(4)
    buffer_store_dwordx4 v[56:59], v136, s[36:39], s56 offen offset:1024 nt
    s_waitcnt lgkmcnt(3)
    buffer_store_dwordx4 v[60:63], v136, s[36:39], s56 offen offset:2048 nt
    s_waitcnt lgkmcnt(2)
    buffer_store_dwordx4 v[64:67], v136, s[36:39], s56 offen offset:3072 nt
    s_waitcnt lgkmcnt(1)
    buffer_store_dwordx4 v[68:71], v136, s[36:39], s58 offen offset:0 nt
    s_waitcnt lgkmcnt(0)
    buffer_store_dwordx4 v[72:75], v136, s[36:39], s58 offen offset:1024 nt
    s_add_u32 s56, s56, 6144
    v_add_u32 v132, 6144, v132
    v_add_u32 v133, 6144, v133
    s_add_u32 s55, s55, 1
    s_cmp_lt_u32 s55, 2
    s_cbranch_scc1 L_tile
L_fin:
L_end:
    s_endpgm
.section .rodata,"a"
.p2align 6
.p2align 6
.amdhsa_kernel standalone__low_rank_proj_linformer__prompt_kernel
  .amdhsa_next_free_vgpr 152
  .amdhsa_next_free_sgpr 94
  .amdhsa_accum_offset 152
  .amdhsa_group_segment_fixed_size 0
  .amdhsa_kernarg_size 64
  .amdhsa_user_sgpr_count 2
  .amdhsa_user_sgpr_kernarg_segment_ptr 1
  .amdhsa_system_sgpr_workgroup_id_x 1
.end_amdhsa_kernel
```
